```python
import torch

def _softmax(x, axis=-1):
    return torch.softmax(x, dim=axis)
def _gelu(x):
    return torch.nn.functional.gelu(x, approximate="tanh")
def _silu(x):
    return torch.nn.functional.silu(x)
def _sigmoid(x):
    return torch.sigmoid(x)
def _layernorm(x, axis=-1, eps=1e-5):
    m = x.mean(dim=axis, keepdim=True)
    v = x.var(dim=axis, keepdim=True, unbiased=False)
    return (x - m) / torch.sqrt(v + eps)
def _scatter_add(tgt, idx, src, axis=0):
    return tgt.clone().index_add_(axis, idx, src)
def _segment_sum(src, seg, n):
    out = torch.zeros((n,) + src.shape[1:], dtype=src.dtype)
    return out.index_add_(0, seg, src)
def _pad(x, pw):
    flat = tuple(v for pair in reversed(pw) for v in pair)
    return torch.nn.functional.pad(x, flat)

kernel_name = 'standalone__low_rank_proj_linformer__decode'

def setup_inputs():

    _w = (lambda a: (lambda t: t.to(torch.bfloat16) if t.is_floating_point() else t)(torch.as_tensor(a)))
    B, H, Sq, Skv, Dh, R = 8, 32, 1, 4096, 128, 8
    return {
        "q": _w((lambda *s: torch.randn(*s, dtype=torch.bfloat16) * 0.8)(B, H, Sq, Dh)),
        "k": _w((lambda *s: torch.randn(*s, dtype=torch.bfloat16) * 0.8)(B, H, Skv, Dh)),
        "v": _w((lambda *s: torch.randn(*s, dtype=torch.bfloat16) * 0.05)(B, H, Skv, Dh)),
        "e_proj": _w((lambda *s: torch.randn(*s, dtype=torch.bfloat16) * 0.8)(R, Skv) * (Skv ** -0.5)),
        "f_proj": _w((lambda *s: torch.randn(*s, dtype=torch.bfloat16) * 0.05)(R, Skv) * (Skv ** -0.5)),
    }

def reference(q, k, v, e_proj, f_proj):
    B, H, Sq, Dh = q.shape
    kp = torch.einsum("rn,bhnd->bhrd", e_proj, k)
    vp = torch.einsum("rn,bhnd->bhrd", f_proj, v)
    scores = torch.einsum("bhqd,bhrd->bhqr", q, kp) * (Dh ** -0.5)
    p = _softmax(scores, axis=-1)
    o = torch.einsum("bhqr,bhrd->bhqd", p, vp)
    return o
```

```asm
; @launch grid=(256,1,1) block=(320,1,1) lds=86016
.amdgcn_target "amdgcn-amd-amdhsa--gfx950"
.text
.globl standalone__low_rank_proj_linformer__decode_kernel
.p2align 8
.type standalone__low_rank_proj_linformer__decode_kernel,@function
standalone__low_rank_proj_linformer__decode_kernel:
    s_load_dwordx8 s[4:11], s[0:1], 0
    s_cmp_ge_u32 s2, 256
    s_cbranch_scc1 L_end
    v_lshrrev_b32 v9, 6, v0
    v_and_b32 v4, 63, v0
    v_readfirstlane_b32 s16, v9
    v_lshlrev_b32 v1, 4, v4
    s_lshl_b32 s17, s2, 20
    s_mov_b32 s22, 0x200000
    s_mov_b32 s23, 0x20000
    s_lshl_b32 s28, s16, 13
    s_cmp_eq_u32 s16, 4
    s_cbranch_scc1 L_helper
    s_waitcnt lgkmcnt(0)
    s_add_u32 s20, s6, s17
    s_addc_u32 s21, s7, 0
    buffer_load_dwordx4 v[16:19], v1, s[20:23], s28 offen nt
    buffer_load_dwordx4 v[20:23], v1, s[20:23], s28 offen offset:1024 nt
    buffer_load_dwordx4 v[24:27], v1, s[20:23], s28 offen offset:2048 nt
    buffer_load_dwordx4 v[28:31], v1, s[20:23], s28 offen offset:3072 nt
    v_add_u32 v8, 0x1000, v1
    buffer_load_dwordx4 v[32:35], v8, s[20:23], s28 offen nt
    buffer_load_dwordx4 v[36:39], v8, s[20:23], s28 offen offset:1024 nt
    s_load_dwordx4 s[12:15], s[0:1], 32
    v_and_b32 v9, 15, v4
    v_lshrrev_b32 v10, 4, v4
    v_and_b32 v11, 7, v9
    v_lshlrev_b32 v2, 13, v11
    v_lshl_add_u32 v2, v10, 4, v2
    s_lshl_b32 s29, s16, 6
    s_mov_b32 s24, s10
    s_mov_b32 s25, s11
    s_mov_b32 s26, 0x12000
    s_mov_b32 s27, 0x20000
    buffer_load_dwordx4 v[48:51], v2, s[24:27], s29 offen
    v_mov_b32 v12, 0
    v_mov_b32 v13, 0
    v_mov_b32 v14, 0
    v_mov_b32 v15, 0
    s_mov_b32 s30, 0x05040100
    s_mov_b32 s31, 0x07060302
    v_mfma_f32_32x32x16_bf16 v[120:135], v[12:15], v[12:15], 0
    v_mfma_f32_32x32x16_bf16 v[136:151], v[12:15], v[12:15], 0
    v_mfma_f32_32x32x16_bf16 v[152:167], v[12:15], v[12:15], 0
    v_mfma_f32_32x32x16_bf16 v[168:183], v[12:15], v[12:15], 0
    s_waitcnt lgkmcnt(0)
    s_add_u32 s44, s8, s17
    s_addc_u32 s45, s9, 0
    s_sub_u32 s44, s44, 0x100000
    s_subb_u32 s45, s45, 0
    s_sub_u32 s46, s12, 0x2000
    s_subb_u32 s47, s13, 0
    s_mov_b32 s40, 0
    s_getreg_b32 s48, hwreg(HW_REG_XCC_ID, 0, 4)
    s_lshr_b32 s48, 170, s48
    s_and_b32 s48, s48, 1
    s_mov_b32 s49, 0
    s_mov_b64 vcc, s[48:49]
    v_mul_u32_u24 v5, 272, v9
    v_lshl_add_u32 v5, v10, 4, v5
    s_mul_i32 s35, s16, 4352
    v_add_u32 v5, s35, v5
    v_lshrrev_b32 v6, 4, v0
    v_mul_u32_u24 v6, 272, v6
    v_and_b32 v11, 15, v0
    v_lshl_add_u32 v6, v11, 4, v6
    v_and_b32 v7, 1, v0
    v_lshlrev_b32 v7, 4, v7
    s_lshl_b32 s19, s2, 8
    s_mov_b32 s36, s14
    s_mov_b32 s37, s15
    s_mov_b32 s38, 0x10000
    s_mov_b32 s39, 0x20000
    s_barrier
    s_waitcnt vmcnt(5)
    buffer_load_dwordx4 v[40:43], v8, s[20:23], s28 offen offset:2048 nt
    s_waitcnt vmcnt(5)
    buffer_load_dwordx4 v[44:47], v8, s[20:23], s28 offen offset:3072 nt
    s_add_u32 s28, s28, 32768
    s_add_u32 s29, s29, 256
    s_waitcnt vmcnt(5)
    buffer_load_dwordx4 v[84:87], v2, s[24:27], s29 offen
    s_waitcnt vmcnt(5)
    buffer_load_dwordx4 v[52:55], v1, s[20:23], s28 offen nt
    s_waitcnt vmcnt(5)
    buffer_load_dwordx4 v[56:59], v1, s[20:23], s28 offen offset:1024 nt
L_loopK:
    s_waitcnt vmcnt(5)
    buffer_load_dwordx4 v[60:63], v1, s[20:23], s28 offen offset:2048 nt
    v_perm_b32 v12, v50, v48, s30
    v_perm_b32 v13, v50, v48, s31
    v_perm_b32 v14, v51, v49, s30
    v_perm_b32 v15, v51, v49, s31
    s_waitcnt vmcnt(5)
    buffer_load_dwordx4 v[64:67], v1, s[20:23], s28 offen offset:3072 nt
    v_permlane32_swap_b32 v12, v14
    v_permlane32_swap_b32 v13, v15
    s_waitcnt vmcnt(5)
    buffer_load_dwordx4 v[68:71], v8, s[20:23], s28 offen nt
    v_perm_b32 v88, v20, v16, s30
    v_perm_b32 v92, v20, v16, s31
    v_perm_b32 v96, v21, v17, s30
    v_perm_b32 v100, v21, v17, s31
    v_perm_b32 v104, v22, v18, s30
    v_perm_b32 v108, v22, v18, s31
    v_perm_b32 v112, v23, v19, s30
    v_perm_b32 v116, v23, v19, s31
    s_waitcnt vmcnt(4)
    buffer_load_dwordx4 v[72:75], v8, s[20:23], s28 offen offset:1024 nt
    v_permlane16_swap_b32 v12, v13
    v_permlane16_swap_b32 v14, v15
    s_waitcnt vmcnt(5)
    s_cbranch_vccz L_loopK_p0_4
    s_waitcnt vmcnt(4)
L_loopK_p0_4:
    buffer_load_dwordx4 v[76:79], v8, s[20:23], s28 offen offset:2048 nt
    v_perm_b32 v89, v28, v24, s30
    v_perm_b32 v93, v28, v24, s31
    v_perm_b32 v97, v29, v25, s30
    v_perm_b32 v101, v29, v25, s31
    v_perm_b32 v105, v30, v26, s30
    v_perm_b32 v109, v30, v26, s31
    v_perm_b32 v113, v31, v27, s30
    v_perm_b32 v117, v31, v27, s31
    s_waitcnt vmcnt(4)
    buffer_load_dwordx4 v[80:83], v8, s[20:23], s28 offen offset:3072 nt
    s_waitcnt vmcnt(5)
    s_add_u32 s28, s28, 32768
    s_add_u32 s29, s29, 256
    s_cmp_eq_u32 s40, 30
    s_cselect_b32 s20, s44, s20
    s_cselect_b32 s21, s45, s21
    s_cselect_b32 s24, s46, s24
    s_cselect_b32 s25, s47, s25
    buffer_load_dwordx4 v[48:51], v2, s[24:27], s29 offen
    v_perm_b32 v90, v36, v32, s30
    v_perm_b32 v94, v36, v32, s31
    v_perm_b32 v98, v37, v33, s30
    v_perm_b32 v102, v37, v33, s31
    v_perm_b32 v106, v38, v34, s30
    v_perm_b32 v110, v38, v34, s31
    v_perm_b32 v114, v39, v35, s30
    v_perm_b32 v118, v39, v35, s31
    s_waitcnt vmcnt(5)
    buffer_load_dwordx4 v[16:19], v1, s[20:23], s28 offen nt
    s_waitcnt vmcnt(5)
    buffer_load_dwordx4 v[20:23], v1, s[20:23], s28 offen offset:1024 nt
    v_perm_b32 v91, v44, v40, s30
    v_perm_b32 v95, v44, v40, s31
    v_perm_b32 v99, v45, v41, s30
    v_perm_b32 v103, v45, v41, s31
    v_perm_b32 v107, v46, v42, s30
    v_perm_b32 v111, v46, v42, s31
    v_perm_b32 v115, v47, v43, s30
    v_perm_b32 v119, v47, v43, s31
    v_mfma_f32_16x16x32_bf16 v[152:155], v[12:15], v[88:91], v[152:155]
    v_mfma_f32_16x16x32_bf16 v[156:159], v[12:15], v[92:95], v[156:159]
    v_mfma_f32_16x16x32_bf16 v[160:163], v[12:15], v[96:99], v[160:163]
    v_mfma_f32_16x16x32_bf16 v[164:167], v[12:15], v[100:103], v[164:167]
    v_mfma_f32_16x16x32_bf16 v[168:171], v[12:15], v[104:107], v[168:171]
    v_mfma_f32_16x16x32_bf16 v[172:175], v[12:15], v[108:111], v[172:175]
    v_mfma_f32_16x16x32_bf16 v[176:179], v[12:15], v[112:115], v[176:179]
    v_mfma_f32_16x16x32_bf16 v[180:183], v[12:15], v[116:119], v[180:183]
    s_waitcnt vmcnt(5)
    buffer_load_dwordx4 v[24:27], v1, s[20:23], s28 offen offset:2048 nt
    v_perm_b32 v12, v86, v84, s30
    v_perm_b32 v13, v86, v84, s31
    v_perm_b32 v14, v87, v85, s30
    v_perm_b32 v15, v87, v85, s31
    s_waitcnt vmcnt(5)
    buffer_load_dwordx4 v[28:31], v1, s[20:23], s28 offen offset:3072 nt
    v_permlane32_swap_b32 v12, v14
    v_permlane32_swap_b32 v13, v15
    s_waitcnt vmcnt(5)
    buffer_load_dwordx4 v[32:35], v8, s[20:23], s28 offen nt
    v_perm_b32 v88, v56, v52, s30
    v_perm_b32 v92, v56, v52, s31
    v_perm_b32 v96, v57, v53, s30
    v_perm_b32 v100, v57, v53, s31
    v_perm_b32 v104, v58, v54, s30
    v_perm_b32 v108, v58, v54, s31
    v_perm_b32 v112, v59, v55, s30
    v_perm_b32 v116, v59, v55, s31
    s_waitcnt vmcnt(4)
    buffer_load_dwordx4 v[36:39], v8, s[20:23], s28 offen offset:1024 nt
    v_permlane16_swap_b32 v12, v13
    v_permlane16_swap_b32 v14, v15
    s_waitcnt vmcnt(5)
    s_cbranch_vccz L_loopK_p1_4
    s_waitcnt vmcnt(4)
L_loopK_p1_4:
    buffer_load_dwordx4 v[40:43], v8, s[20:23], s28 offen offset:2048 nt
    v_perm_b32 v89, v64, v60, s30
    v_perm_b32 v93, v64, v60, s31
    v_perm_b32 v97, v65, v61, s30
    v_perm_b32 v101, v65, v61, s31
    v_perm_b32 v105, v66, v62, s30
    v_perm_b32 v109, v66, v62, s31
    v_perm_b32 v113, v67, v63, s30
    v_perm_b32 v117, v67, v63, s31
    s_waitcnt vmcnt(4)
    buffer_load_dwordx4 v[44:47], v8, s[20:23], s28 offen offset:3072 nt
    s_waitcnt vmcnt(5)
    s_add_u32 s28, s28, 32768
    s_add_u32 s29, s29, 256
    s_cmp_eq_u32 s40, 29
    s_cselect_b32 s20, s44, s20
    s_cselect_b32 s21, s45, s21
    s_cselect_b32 s24, s46, s24
    s_cselect_b32 s25, s47, s25
    buffer_load_dwordx4 v[84:87], v2, s[24:27], s29 offen
    v_perm_b32 v90, v72, v68, s30
    v_perm_b32 v94, v72, v68, s31
    v_perm_b32 v98, v73, v69, s30
    v_perm_b32 v102, v73, v69, s31
    v_perm_b32 v106, v74, v70, s30
    v_perm_b32 v110, v74, v70, s31
    v_perm_b32 v114, v75, v71, s30
    v_perm_b32 v118, v75, v71, s31
    s_waitcnt vmcnt(5)
    buffer_load_dwordx4 v[52:55], v1, s[20:23], s28 offen nt
    s_waitcnt vmcnt(5)
    buffer_load_dwordx4 v[56:59], v1, s[20:23], s28 offen offset:1024 nt
    v_perm_b32 v91, v80, v76, s30
    v_perm_b32 v95, v80, v76, s31
    v_perm_b32 v99, v81, v77, s30
    v_perm_b32 v103, v81, v77, s31
    v_perm_b32 v107, v82, v78, s30
    v_perm_b32 v111, v82, v78, s31
    v_perm_b32 v115, v83, v79, s30
    v_perm_b32 v119, v83, v79, s31
    v_mfma_f32_16x16x32_bf16 v[152:155], v[12:15], v[88:91], v[152:155]
    v_mfma_f32_16x16x32_bf16 v[156:159], v[12:15], v[92:95], v[156:159]
    v_mfma_f32_16x16x32_bf16 v[160:163], v[12:15], v[96:99], v[160:163]
    v_mfma_f32_16x16x32_bf16 v[164:167], v[12:15], v[100:103], v[164:167]
    v_mfma_f32_16x16x32_bf16 v[168:171], v[12:15], v[104:107], v[168:171]
    v_mfma_f32_16x16x32_bf16 v[172:175], v[12:15], v[108:111], v[172:175]
    v_mfma_f32_16x16x32_bf16 v[176:179], v[12:15], v[112:115], v[176:179]
    v_mfma_f32_16x16x32_bf16 v[180:183], v[12:15], v[116:119], v[180:183]
    s_add_u32 s40, s40, 2
    s_cmp_lt_u32 s40, 32
    s_cbranch_scc1 L_loopK
    v_mov_b32 v9, 34848
    v_mov_b32 v10, 1
    s_nop 3
    s_mov_b32 exec_hi, 0
    ds_write_b128 v5, v[152:155] offset:0
    ds_write_b128 v5, v[156:159] offset:32
    ds_write_b128 v5, v[160:163] offset:64
    ds_write_b128 v5, v[164:167] offset:96
    ds_write_b128 v5, v[168:171] offset:128
    ds_write_b128 v5, v[172:175] offset:160
    ds_write_b128 v5, v[176:179] offset:192
    ds_write_b128 v5, v[180:183] offset:224
    s_mov_b32 exec_hi, -1
    s_mov_b32 exec_lo, 1
    s_mov_b32 exec_hi, 0
    ds_add_u32 v9, v10
    s_mov_b32 exec_lo, -1
    s_mov_b32 exec_hi, -1
L_loop:
    s_waitcnt vmcnt(5)
    buffer_load_dwordx4 v[60:63], v1, s[20:23], s28 offen offset:2048 nt
    v_perm_b32 v12, v50, v48, s30
    v_perm_b32 v13, v50, v48, s31
    v_perm_b32 v14, v51, v49, s30
    v_perm_b32 v15, v51, v49, s31
    s_waitcnt vmcnt(5)
    buffer_load_dwordx4 v[64:67], v1, s[20:23], s28 offen offset:3072 nt
    v_permlane32_swap_b32 v12, v14
    v_permlane32_swap_b32 v13, v15
    s_waitcnt vmcnt(5)
    buffer_load_dwordx4 v[68:71], v8, s[20:23], s28 offen nt
    v_perm_b32 v88, v20, v16, s30
    v_perm_b32 v92, v20, v16, s31
    v_perm_b32 v96, v21, v17, s30
    v_perm_b32 v100, v21, v17, s31
    v_perm_b32 v104, v22, v18, s30
    v_perm_b32 v108, v22, v18, s31
    v_perm_b32 v112, v23, v19, s30
    v_perm_b32 v116, v23, v19, s31
    s_waitcnt vmcnt(4)
    buffer_load_dwordx4 v[72:75], v8, s[20:23], s28 offen offset:1024 nt
    v_permlane16_swap_b32 v12, v13
    v_permlane16_swap_b32 v14, v15
    s_waitcnt vmcnt(5)
    s_cbranch_vccz L_loop_p0_4
    s_waitcnt vmcnt(4)
L_loop_p0_4:
    buffer_load_dwordx4 v[76:79], v8, s[20:23], s28 offen offset:2048 nt
    v_perm_b32 v89, v28, v24, s30
    v_perm_b32 v93, v28, v24, s31
    v_perm_b32 v97, v29, v25, s30
    v_perm_b32 v101, v29, v25, s31
    v_perm_b32 v105, v30, v26, s30
    v_perm_b32 v109, v30, v26, s31
    v_perm_b32 v113, v31, v27, s30
    v_perm_b32 v117, v31, v27, s31
    s_waitcnt vmcnt(4)
    buffer_load_dwordx4 v[80:83], v8, s[20:23], s28 offen offset:3072 nt
    s_waitcnt vmcnt(5)
    s_add_u32 s28, s28, 32768
    s_add_u32 s29, s29, 256
    buffer_load_dwordx4 v[48:51], v2, s[24:27], s29 offen
    v_perm_b32 v90, v36, v32, s30
    v_perm_b32 v94, v36, v32, s31
    v_perm_b32 v98, v37, v33, s30
    v_perm_b32 v102, v37, v33, s31
    v_perm_b32 v106, v38, v34, s30
    v_perm_b32 v110, v38, v34, s31
    v_perm_b32 v114, v39, v35, s30
    v_perm_b32 v118, v39, v35, s31
    s_waitcnt vmcnt(5)
    buffer_load_dwordx4 v[16:19], v1, s[20:23], s28 offen nt
    s_waitcnt vmcnt(5)
    buffer_load_dwordx4 v[20:23], v1, s[20:23], s28 offen offset:1024 nt
    v_perm_b32 v91, v44, v40, s30
    v_perm_b32 v95, v44, v40, s31
    v_perm_b32 v99, v45, v41, s30
    v_perm_b32 v103, v45, v41, s31
    v_perm_b32 v107, v46, v42, s30
    v_perm_b32 v111, v46, v42, s31
    v_perm_b32 v115, v47, v43, s30
    v_perm_b32 v119, v47, v43, s31
    v_mfma_f32_16x16x32_bf16 v[120:123], v[12:15], v[88:91], v[120:123]
    v_mfma_f32_16x16x32_bf16 v[124:127], v[12:15], v[92:95], v[124:127]
    v_mfma_f32_16x16x32_bf16 v[128:131], v[12:15], v[96:99], v[128:131]
    v_mfma_f32_16x16x32_bf16 v[132:135], v[12:15], v[100:103], v[132:135]
    v_mfma_f32_16x16x32_bf16 v[136:139], v[12:15], v[104:107], v[136:139]
    v_mfma_f32_16x16x32_bf16 v[140:143], v[12:15], v[108:111], v[140:143]
    v_mfma_f32_16x16x32_bf16 v[144:147], v[12:15], v[112:115], v[144:147]
    v_mfma_f32_16x16x32_bf16 v[148:151], v[12:15], v[116:119], v[148:151]
    s_waitcnt vmcnt(5)
    buffer_load_dwordx4 v[24:27], v1, s[20:23], s28 offen offset:2048 nt
    v_perm_b32 v12, v86, v84, s30
    v_perm_b32 v13, v86, v84, s31
    v_perm_b32 v14, v87, v85, s30
    v_perm_b32 v15, v87, v85, s31
    s_waitcnt vmcnt(5)
    buffer_load_dwordx4 v[28:31], v1, s[20:23], s28 offen offset:3072 nt
    v_permlane32_swap_b32 v12, v14
    v_permlane32_swap_b32 v13, v15
    s_waitcnt vmcnt(5)
    buffer_load_dwordx4 v[32:35], v8, s[20:23], s28 offen nt
    v_perm_b32 v88, v56, v52, s30
    v_perm_b32 v92, v56, v52, s31
    v_perm_b32 v96, v57, v53, s30
    v_perm_b32 v100, v57, v53, s31
    v_perm_b32 v104, v58, v54, s30
    v_perm_b32 v108, v58, v54, s31
    v_perm_b32 v112, v59, v55, s30
    v_perm_b32 v116, v59, v55, s31
    s_waitcnt vmcnt(4)
    buffer_load_dwordx4 v[36:39], v8, s[20:23], s28 offen offset:1024 nt
    v_permlane16_swap_b32 v12, v13
    v_permlane16_swap_b32 v14, v15
    s_waitcnt vmcnt(5)
    s_cbranch_vccz L_loop_p1_4
    s_waitcnt vmcnt(4)
L_loop_p1_4:
    buffer_load_dwordx4 v[40:43], v8, s[20:23], s28 offen offset:2048 nt
    v_perm_b32 v89, v64, v60, s30
    v_perm_b32 v93, v64, v60, s31
    v_perm_b32 v97, v65, v61, s30
    v_perm_b32 v101, v65, v61, s31
    v_perm_b32 v105, v66, v62, s30
    v_perm_b32 v109, v66, v62, s31
    v_perm_b32 v113, v67, v63, s30
    v_perm_b32 v117, v67, v63, s31
    s_waitcnt vmcnt(4)
    buffer_load_dwordx4 v[44:47], v8, s[20:23], s28 offen offset:3072 nt
    s_waitcnt vmcnt(5)
    s_add_u32 s28, s28, 32768
    s_add_u32 s29, s29, 256
    buffer_load_dwordx4 v[84:87], v2, s[24:27], s29 offen
    v_perm_b32 v90, v72, v68, s30
    v_perm_b32 v94, v72, v68, s31
    v_perm_b32 v98, v73, v69, s30
    v_perm_b32 v102, v73, v69, s31
    v_perm_b32 v106, v74, v70, s30
    v_perm_b32 v110, v74, v70, s31
    v_perm_b32 v114, v75, v71, s30
    v_perm_b32 v118, v75, v71, s31
    s_waitcnt vmcnt(5)
    buffer_load_dwordx4 v[52:55], v1, s[20:23], s28 offen nt
    s_waitcnt vmcnt(5)
    buffer_load_dwordx4 v[56:59], v1, s[20:23], s28 offen offset:1024 nt
    v_perm_b32 v91, v80, v76, s30
    v_perm_b32 v95, v80, v76, s31
    v_perm_b32 v99, v81, v77, s30
    v_perm_b32 v103, v81, v77, s31
    v_perm_b32 v107, v82, v78, s30
    v_perm_b32 v111, v82, v78, s31
    v_perm_b32 v115, v83, v79, s30
    v_perm_b32 v119, v83, v79, s31
    v_mfma_f32_16x16x32_bf16 v[120:123], v[12:15], v[88:91], v[120:123]
    v_mfma_f32_16x16x32_bf16 v[124:127], v[12:15], v[92:95], v[124:127]
    v_mfma_f32_16x16x32_bf16 v[128:131], v[12:15], v[96:99], v[128:131]
    v_mfma_f32_16x16x32_bf16 v[132:135], v[12:15], v[100:103], v[132:135]
    v_mfma_f32_16x16x32_bf16 v[136:139], v[12:15], v[104:107], v[136:139]
    v_mfma_f32_16x16x32_bf16 v[140:143], v[12:15], v[108:111], v[140:143]
    v_mfma_f32_16x16x32_bf16 v[144:147], v[12:15], v[112:115], v[144:147]
    v_mfma_f32_16x16x32_bf16 v[148:151], v[12:15], v[116:119], v[148:151]
    s_add_u32 s40, s40, 2
    s_cmp_lt_u32 s40, 62
    s_cbranch_scc1 L_loop
L_tail:
    s_waitcnt vmcnt(11)
    buffer_load_dwordx4 v[60:63], v1, s[20:23], s28 offen offset:2048 nt
    v_perm_b32 v12, v50, v48, s30
    v_perm_b32 v13, v50, v48, s31
    v_perm_b32 v14, v51, v49, s30
    v_perm_b32 v15, v51, v49, s31
    s_waitcnt vmcnt(11)
    buffer_load_dwordx4 v[64:67], v1, s[20:23], s28 offen offset:3072 nt
    v_permlane32_swap_b32 v12, v14
    v_permlane32_swap_b32 v13, v15
    s_waitcnt vmcnt(11)
    buffer_load_dwordx4 v[68:71], v8, s[20:23], s28 offen nt
    v_perm_b32 v88, v20, v16, s30
    v_perm_b32 v92, v20, v16, s31
    v_perm_b32 v96, v21, v17, s30
    v_perm_b32 v100, v21, v17, s31
    v_perm_b32 v104, v22, v18, s30
    v_perm_b32 v108, v22, v18, s31
    v_perm_b32 v112, v23, v19, s30
    v_perm_b32 v116, v23, v19, s31
    s_waitcnt vmcnt(11)
    buffer_load_dwordx4 v[72:75], v8, s[20:23], s28 offen offset:1024 nt
    v_permlane16_swap_b32 v12, v13
    v_permlane16_swap_b32 v14, v15
    s_waitcnt vmcnt(11)
    buffer_load_dwordx4 v[76:79], v8, s[20:23], s28 offen offset:2048 nt
    v_perm_b32 v89, v28, v24, s30
    v_perm_b32 v93, v28, v24, s31
    v_perm_b32 v97, v29, v25, s30
    v_perm_b32 v101, v29, v25, s31
    v_perm_b32 v105, v30, v26, s30
    v_perm_b32 v109, v30, v26, s31
    v_perm_b32 v113, v31, v27, s30
    v_perm_b32 v117, v31, v27, s31
    s_waitcnt vmcnt(11)
    buffer_load_dwordx4 v[80:83], v8, s[20:23], s28 offen offset:3072 nt
    s_waitcnt vmcnt(11)
    s_add_u32 s28, s28, 32768
    s_add_u32 s29, s29, 256
    buffer_load_dwordx4 v[48:51], v2, s[24:27], s29 offen
    v_perm_b32 v90, v36, v32, s30
    v_perm_b32 v94, v36, v32, s31
    v_perm_b32 v98, v37, v33, s30
    v_perm_b32 v102, v37, v33, s31
    v_perm_b32 v106, v38, v34, s30
    v_perm_b32 v110, v38, v34, s31
    v_perm_b32 v114, v39, v35, s30
    v_perm_b32 v118, v39, v35, s31
    s_waitcnt vmcnt(11)
    buffer_load_dwordx4 v[16:19], v1, s[20:23], s28 offen nt
    s_waitcnt vmcnt(11)
    buffer_load_dwordx4 v[20:23], v1, s[20:23], s28 offen offset:1024 nt
    v_perm_b32 v91, v44, v40, s30
    v_perm_b32 v95, v44, v40, s31
    v_perm_b32 v99, v45, v41, s30
    v_perm_b32 v103, v45, v41, s31
    v_perm_b32 v107, v46, v42, s30
    v_perm_b32 v111, v46, v42, s31
    v_perm_b32 v115, v47, v43, s30
    v_perm_b32 v119, v47, v43, s31
    v_mfma_f32_16x16x32_bf16 v[120:123], v[12:15], v[88:91], v[120:123]
    v_mfma_f32_16x16x32_bf16 v[124:127], v[12:15], v[92:95], v[124:127]
    v_mfma_f32_16x16x32_bf16 v[128:131], v[12:15], v[96:99], v[128:131]
    v_mfma_f32_16x16x32_bf16 v[132:135], v[12:15], v[100:103], v[132:135]
    v_mfma_f32_16x16x32_bf16 v[136:139], v[12:15], v[104:107], v[136:139]
    v_mfma_f32_16x16x32_bf16 v[140:143], v[12:15], v[108:111], v[140:143]
    v_mfma_f32_16x16x32_bf16 v[144:147], v[12:15], v[112:115], v[144:147]
    v_mfma_f32_16x16x32_bf16 v[148:151], v[12:15], v[116:119], v[148:151]
    s_waitcnt vmcnt(11)
    buffer_load_dwordx4 v[24:27], v1, s[20:23], s28 offen offset:2048 nt
    v_perm_b32 v12, v86, v84, s30
    v_perm_b32 v13, v86, v84, s31
    v_perm_b32 v14, v87, v85, s30
    v_perm_b32 v15, v87, v85, s31
    s_waitcnt vmcnt(11)
    buffer_load_dwordx4 v[28:31], v1, s[20:23], s28 offen offset:3072 nt
    v_permlane32_swap_b32 v12, v14
    v_permlane32_swap_b32 v13, v15
    s_waitcnt vmcnt(11)
    buffer_load_dwordx4 v[32:35], v8, s[20:23], s28 offen nt
    v_perm_b32 v88, v56, v52, s30
    v_perm_b32 v92, v56, v52, s31
    v_perm_b32 v96, v57, v53, s30
    v_perm_b32 v100, v57, v53, s31
    v_perm_b32 v104, v58, v54, s30
    v_perm_b32 v108, v58, v54, s31
    v_perm_b32 v112, v59, v55, s30
    v_perm_b32 v116, v59, v55, s31
    s_waitcnt vmcnt(11)
    buffer_load_dwordx4 v[36:39], v8, s[20:23], s28 offen offset:1024 nt
    v_permlane16_swap_b32 v12, v13
    v_permlane16_swap_b32 v14, v15
    s_waitcnt vmcnt(11)
    buffer_load_dwordx4 v[40:43], v8, s[20:23], s28 offen offset:2048 nt
    v_perm_b32 v89, v64, v60, s30
    v_perm_b32 v93, v64, v60, s31
    v_perm_b32 v97, v65, v61, s30
    v_perm_b32 v101, v65, v61, s31
    v_perm_b32 v105, v66, v62, s30
    v_perm_b32 v109, v66, v62, s31
    v_perm_b32 v113, v67, v63, s30
    v_perm_b32 v117, v67, v63, s31
    s_waitcnt vmcnt(11)
    buffer_load_dwordx4 v[44:47], v8, s[20:23], s28 offen offset:3072 nt
    s_waitcnt vmcnt(11)
    s_add_u32 s28, s28, 32768
    s_add_u32 s29, s29, 256
    buffer_load_dwordx4 v[84:87], v2, s[24:27], s29 offen
    v_perm_b32 v90, v72, v68, s30
    v_perm_b32 v94, v72, v68, s31
    v_perm_b32 v98, v73, v69, s30
    v_perm_b32 v102, v73, v69, s31
    v_perm_b32 v106, v74, v70, s30
    v_perm_b32 v110, v74, v70, s31
    v_perm_b32 v114, v75, v71, s30
    v_perm_b32 v118, v75, v71, s31
    s_waitcnt vmcnt(11)
    buffer_load_dwordx4 v[52:55], v1, s[20:23], s28 offen nt
    s_waitcnt vmcnt(11)
    buffer_load_dwordx4 v[56:59], v1, s[20:23], s28 offen offset:1024 nt
    v_perm_b32 v91, v80, v76, s30
    v_perm_b32 v95, v80, v76, s31
    v_perm_b32 v99, v81, v77, s30
    v_perm_b32 v103, v81, v77, s31
    v_perm_b32 v107, v82, v78, s30
    v_perm_b32 v111, v82, v78, s31
    v_perm_b32 v115, v83, v79, s30
    v_perm_b32 v119, v83, v79, s31
    v_mfma_f32_16x16x32_bf16 v[120:123], v[12:15], v[88:91], v[120:123]
    v_mfma_f32_16x16x32_bf16 v[124:127], v[12:15], v[92:95], v[124:127]
    v_mfma_f32_16x16x32_bf16 v[128:131], v[12:15], v[96:99], v[128:131]
    v_mfma_f32_16x16x32_bf16 v[132:135], v[12:15], v[100:103], v[132:135]
    v_mfma_f32_16x16x32_bf16 v[136:139], v[12:15], v[104:107], v[136:139]
    v_mfma_f32_16x16x32_bf16 v[140:143], v[12:15], v[108:111], v[140:143]
    v_mfma_f32_16x16x32_bf16 v[144:147], v[12:15], v[112:115], v[144:147]
    v_mfma_f32_16x16x32_bf16 v[148:151], v[12:15], v[116:119], v[148:151]
    s_add_u32 s40, s40, 2
    s_cmp_lt_u32 s40, 64
    s_cbranch_scc1 L_tail
L_taildone:
    s_nop 5
    s_mov_b32 exec_hi, 0
    ds_write_b128 v5, v[120:123] offset:17408
    ds_write_b128 v5, v[124:127] offset:17440
    ds_write_b128 v5, v[128:131] offset:17472
    ds_write_b128 v5, v[132:135] offset:17504
    ds_write_b128 v5, v[136:139] offset:17536
    ds_write_b128 v5, v[140:143] offset:17568
    ds_write_b128 v5, v[144:147] offset:17600
    ds_write_b128 v5, v[148:151] offset:17632
    s_mov_b32 exec_hi, -1
    s_waitcnt lgkmcnt(0)
    s_barrier
    ds_read_b128 v[88:91], v6 offset:17408
    ds_read_b128 v[92:95], v6 offset:21760
    ds_read_b128 v[96:99], v6 offset:26112
    ds_read_b128 v[100:103], v6 offset:30464
    ds_read_b128 v[104:107], v7 offset:34816
    s_waitcnt lgkmcnt(3)
    v_add_f32 v88, v88, v92
    v_add_f32 v89, v89, v93
    v_add_f32 v90, v90, v94
    v_add_f32 v91, v91, v95
    s_waitcnt lgkmcnt(2)
    v_add_f32 v88, v88, v96
    v_add_f32 v89, v89, v97
    v_add_f32 v90, v90, v98
    v_add_f32 v91, v91, v99
    s_waitcnt lgkmcnt(1)
    v_add_f32 v88, v88, v100
    v_add_f32 v89, v89, v101
    v_add_f32 v90, v90, v102
    v_add_f32 v91, v91, v103
    v_cvt_pk_bf16_f32 v92, v88, v89
    v_cvt_pk_bf16_f32 v93, v90, v91
    v_lshlrev_b32 v88, 16, v92
    v_and_b32 v89, 0xffff0000, v92
    v_lshlrev_b32 v90, 16, v93
    v_and_b32 v91, 0xffff0000, v93
    s_waitcnt lgkmcnt(0)
    v_mul_f32 v11, v88, v104
    v_fmac_f32 v11, v89, v105
    v_fmac_f32 v11, v90, v106
    v_fmac_f32 v11, v91, v107
    s_nop 1
    v_add_f32_dpp v11, v11, v11 quad_perm:[1,0,3,2] row_mask:0xf bank_mask:0xf
    s_nop 1
    v_mov_b32_dpp v10, v11 quad_perm:[2,3,0,1] row_mask:0xf bank_mask:0xf
    v_cvt_pk_bf16_f32 v11, v11, v10
    s_mov_b32 exec_lo, 0x11111111
    s_mov_b32 exec_hi, 0x11111111
    buffer_store_dword v11, v0, s[36:39], s19 offen sc0 sc1
    s_endpgm
L_helper:
    v_mov_b32 v5, 34848
    v_mov_b32 v6, 0
    ds_write_b32 v5, v6
    s_lshl_b32 s19, s2, 8
    v_lshlrev_b32 v6, 2, v4
    s_mov_b32 s34, 0x10000
    s_mov_b32 s35, 0x20000
    s_waitcnt lgkmcnt(0)
    s_barrier
    s_mov_b32 s32, s4
    s_mov_b32 s33, s5
    buffer_load_dword v3, v6, s[32:35], s19 offen
    v_lshrrev_b32 v9, 2, v4
    v_and_b32 v6, 3, v4
    v_mul_u32_u24 v9, 272, v9
    v_lshl_add_u32 v9, v6, 6, v9
L_poll:
    s_sleep 8
    ds_read_b32 v6, v5
    s_waitcnt lgkmcnt(0)
    v_readfirstlane_b32 s26, v6
    s_nop 3
    s_cmp_lt_u32 s26, 4
    s_cbranch_scc1 L_poll
    ds_read_b128 v[12:15], v9 offset:0
    ds_read_b128 v[16:19], v9 offset:16
    ds_read_b128 v[20:23], v9 offset:32
    ds_read_b128 v[24:27], v9 offset:48
    ds_read_b128 v[28:31], v9 offset:4352
    ds_read_b128 v[32:35], v9 offset:4368
    ds_read_b128 v[36:39], v9 offset:4384
    ds_read_b128 v[40:43], v9 offset:4400
    ds_read_b128 v[44:47], v9 offset:8704
    ds_read_b128 v[48:51], v9 offset:8720
    ds_read_b128 v[52:55], v9 offset:8736
    ds_read_b128 v[56:59], v9 offset:8752
    ds_read_b128 v[60:63], v9 offset:13056
    ds_read_b128 v[64:67], v9 offset:13072
    ds_read_b128 v[68:71], v9 offset:13088
    ds_read_b128 v[72:75], v9 offset:13104
    s_waitcnt vmcnt(0) lgkmcnt(0)
    v_add_f32 v12, v12, v28
    v_add_f32 v13, v13, v29
    v_add_f32 v14, v14, v30
    v_add_f32 v15, v15, v31
    v_add_f32 v16, v16, v32
    v_add_f32 v17, v17, v33
    v_add_f32 v18, v18, v34
    v_add_f32 v19, v19, v35
    v_add_f32 v20, v20, v36
    v_add_f32 v21, v21, v37
    v_add_f32 v22, v22, v38
    v_add_f32 v23, v23, v39
    v_add_f32 v24, v24, v40
    v_add_f32 v25, v25, v41
    v_add_f32 v26, v26, v42
    v_add_f32 v27, v27, v43
    v_add_f32 v12, v12, v44
    v_add_f32 v13, v13, v45
    v_add_f32 v14, v14, v46
    v_add_f32 v15, v15, v47
    v_add_f32 v16, v16, v48
    v_add_f32 v17, v17, v49
    v_add_f32 v18, v18, v50
    v_add_f32 v19, v19, v51
    v_add_f32 v20, v20, v52
    v_add_f32 v21, v21, v53
    v_add_f32 v22, v22, v54
    v_add_f32 v23, v23, v55
    v_add_f32 v24, v24, v56
    v_add_f32 v25, v25, v57
    v_add_f32 v26, v26, v58
    v_add_f32 v27, v27, v59
    v_add_f32 v12, v12, v60
    v_add_f32 v13, v13, v61
    v_add_f32 v14, v14, v62
    v_add_f32 v15, v15, v63
    v_add_f32 v16, v16, v64
    v_add_f32 v17, v17, v65
    v_add_f32 v18, v18, v66
    v_add_f32 v19, v19, v67
    v_add_f32 v20, v20, v68
    v_add_f32 v21, v21, v69
    v_add_f32 v22, v22, v70
    v_add_f32 v23, v23, v71
    v_add_f32 v24, v24, v72
    v_add_f32 v25, v25, v73
    v_add_f32 v26, v26, v74
    v_add_f32 v27, v27, v75
    v_cvt_pk_bf16_f32 v28, v12, v20
    v_cvt_pk_bf16_f32 v29, v13, v21
    v_cvt_pk_bf16_f32 v30, v14, v22
    v_cvt_pk_bf16_f32 v31, v15, v23
    v_cvt_pk_bf16_f32 v32, v16, v24
    v_cvt_pk_bf16_f32 v33, v17, v25
    v_cvt_pk_bf16_f32 v34, v18, v26
    v_cvt_pk_bf16_f32 v35, v19, v27
    v_lshlrev_b32 v6, 16, v3
    v_and_b32 v7, 0xffff0000, v3
    v_lshlrev_b32 v12, 16, v28
    v_and_b32 v20, 0xffff0000, v28
    v_lshlrev_b32 v13, 16, v29
    v_and_b32 v21, 0xffff0000, v29
    v_lshlrev_b32 v14, 16, v30
    v_and_b32 v22, 0xffff0000, v30
    v_lshlrev_b32 v15, 16, v31
    v_and_b32 v23, 0xffff0000, v31
    v_lshlrev_b32 v16, 16, v32
    v_and_b32 v24, 0xffff0000, v32
    v_lshlrev_b32 v17, 16, v33
    v_and_b32 v25, 0xffff0000, v33
    v_lshlrev_b32 v18, 16, v34
    v_and_b32 v26, 0xffff0000, v34
    v_lshlrev_b32 v19, 16, v35
    v_and_b32 v27, 0xffff0000, v35
    v_mul_f32 v28, v6, v12
    v_mul_f32 v29, v6, v13
    v_mul_f32 v30, v6, v14
    v_mul_f32 v31, v6, v15
    v_mul_f32 v32, v6, v16
    v_mul_f32 v33, v6, v17
    v_mul_f32 v34, v6, v18
    v_mul_f32 v35, v6, v19
    v_fmac_f32 v28, v7, v20
    v_fmac_f32 v29, v7, v21
    v_fmac_f32 v30, v7, v22
    v_fmac_f32 v31, v7, v23
    v_fmac_f32 v32, v7, v24
    v_fmac_f32 v33, v7, v25
    v_fmac_f32 v34, v7, v26
    v_fmac_f32 v35, v7, v27
    s_nop 1
    v_add_f32_dpp v28, v28, v28 row_shr:1 row_mask:0xf bank_mask:0xf bound_ctrl:0
    v_add_f32_dpp v29, v29, v29 row_shr:1 row_mask:0xf bank_mask:0xf bound_ctrl:0
    v_add_f32_dpp v30, v30, v30 row_shr:1 row_mask:0xf bank_mask:0xf bound_ctrl:0
    v_add_f32_dpp v31, v31, v31 row_shr:1 row_mask:0xf bank_mask:0xf bound_ctrl:0
    v_add_f32_dpp v32, v32, v32 row_shr:1 row_mask:0xf bank_mask:0xf bound_ctrl:0
    v_add_f32_dpp v33, v33, v33 row_shr:1 row_mask:0xf bank_mask:0xf bound_ctrl:0
    v_add_f32_dpp v34, v34, v34 row_shr:1 row_mask:0xf bank_mask:0xf bound_ctrl:0
    v_add_f32_dpp v35, v35, v35 row_shr:1 row_mask:0xf bank_mask:0xf bound_ctrl:0
    s_nop 1
    v_add_f32_dpp v28, v28, v28 row_shr:2 row_mask:0xf bank_mask:0xf bound_ctrl:0
    v_add_f32_dpp v29, v29, v29 row_shr:2 row_mask:0xf bank_mask:0xf bound_ctrl:0
    v_add_f32_dpp v30, v30, v30 row_shr:2 row_mask:0xf bank_mask:0xf bound_ctrl:0
    v_add_f32_dpp v31, v31, v31 row_shr:2 row_mask:0xf bank_mask:0xf bound_ctrl:0
    v_add_f32_dpp v32, v32, v32 row_shr:2 row_mask:0xf bank_mask:0xf bound_ctrl:0
    v_add_f32_dpp v33, v33, v33 row_shr:2 row_mask:0xf bank_mask:0xf bound_ctrl:0
    v_add_f32_dpp v34, v34, v34 row_shr:2 row_mask:0xf bank_mask:0xf bound_ctrl:0
    v_add_f32_dpp v35, v35, v35 row_shr:2 row_mask:0xf bank_mask:0xf bound_ctrl:0
    s_nop 1
    v_add_f32_dpp v28, v28, v28 row_shr:4 row_mask:0xf bank_mask:0xf bound_ctrl:0
    v_add_f32_dpp v29, v29, v29 row_shr:4 row_mask:0xf bank_mask:0xf bound_ctrl:0
    v_add_f32_dpp v30, v30, v30 row_shr:4 row_mask:0xf bank_mask:0xf bound_ctrl:0
    v_add_f32_dpp v31, v31, v31 row_shr:4 row_mask:0xf bank_mask:0xf bound_ctrl:0
    v_add_f32_dpp v32, v32, v32 row_shr:4 row_mask:0xf bank_mask:0xf bound_ctrl:0
    v_add_f32_dpp v33, v33, v33 row_shr:4 row_mask:0xf bank_mask:0xf bound_ctrl:0
    v_add_f32_dpp v34, v34, v34 row_shr:4 row_mask:0xf bank_mask:0xf bound_ctrl:0
    v_add_f32_dpp v35, v35, v35 row_shr:4 row_mask:0xf bank_mask:0xf bound_ctrl:0
    s_nop 1
    v_add_f32_dpp v28, v28, v28 row_shr:8 row_mask:0xf bank_mask:0xf bound_ctrl:0
    v_add_f32_dpp v29, v29, v29 row_shr:8 row_mask:0xf bank_mask:0xf bound_ctrl:0
    v_add_f32_dpp v30, v30, v30 row_shr:8 row_mask:0xf bank_mask:0xf bound_ctrl:0
    v_add_f32_dpp v31, v31, v31 row_shr:8 row_mask:0xf bank_mask:0xf bound_ctrl:0
    v_add_f32_dpp v32, v32, v32 row_shr:8 row_mask:0xf bank_mask:0xf bound_ctrl:0
    v_add_f32_dpp v33, v33, v33 row_shr:8 row_mask:0xf bank_mask:0xf bound_ctrl:0
    v_add_f32_dpp v34, v34, v34 row_shr:8 row_mask:0xf bank_mask:0xf bound_ctrl:0
    v_add_f32_dpp v35, v35, v35 row_shr:8 row_mask:0xf bank_mask:0xf bound_ctrl:0
    s_nop 1
    v_add_f32_dpp v28, v28, v28 row_bcast:15 row_mask:0xa bank_mask:0xf
    v_add_f32_dpp v29, v29, v29 row_bcast:15 row_mask:0xa bank_mask:0xf
    v_add_f32_dpp v30, v30, v30 row_bcast:15 row_mask:0xa bank_mask:0xf
    v_add_f32_dpp v31, v31, v31 row_bcast:15 row_mask:0xa bank_mask:0xf
    v_add_f32_dpp v32, v32, v32 row_bcast:15 row_mask:0xa bank_mask:0xf
    v_add_f32_dpp v33, v33, v33 row_bcast:15 row_mask:0xa bank_mask:0xf
    v_add_f32_dpp v34, v34, v34 row_bcast:15 row_mask:0xa bank_mask:0xf
    v_add_f32_dpp v35, v35, v35 row_bcast:15 row_mask:0xa bank_mask:0xf
    s_nop 1
    v_add_f32_dpp v28, v28, v28 row_bcast:31 row_mask:0xc bank_mask:0xf
    v_add_f32_dpp v29, v29, v29 row_bcast:31 row_mask:0xc bank_mask:0xf
    v_add_f32_dpp v30, v30, v30 row_bcast:31 row_mask:0xc bank_mask:0xf
    v_add_f32_dpp v31, v31, v31 row_bcast:31 row_mask:0xc bank_mask:0xf
    v_add_f32_dpp v32, v32, v32 row_bcast:31 row_mask:0xc bank_mask:0xf
    v_add_f32_dpp v33, v33, v33 row_bcast:31 row_mask:0xc bank_mask:0xf
    v_add_f32_dpp v34, v34, v34 row_bcast:31 row_mask:0xc bank_mask:0xf
    v_add_f32_dpp v35, v35, v35 row_bcast:31 row_mask:0xc bank_mask:0xf
    s_nop 1
    v_readlane_b32 s64, v28, 63
    v_readlane_b32 s65, v29, 63
    v_readlane_b32 s66, v30, 63
    v_readlane_b32 s67, v31, 63
    v_readlane_b32 s68, v32, 63
    v_readlane_b32 s69, v33, 63
    v_readlane_b32 s70, v34, 63
    v_readlane_b32 s71, v35, 63
    s_nop 1
    v_mov_b32 v28, s64
    v_mov_b32 v29, s65
    v_mov_b32 v30, s66
    v_mov_b32 v31, s67
    v_mov_b32 v32, s68
    v_mov_b32 v33, s69
    v_mov_b32 v34, s70
    v_mov_b32 v35, s71
    v_cvt_pk_bf16_f32 v36, v28, v29
    v_cvt_pk_bf16_f32 v37, v30, v31
    v_cvt_pk_bf16_f32 v38, v32, v33
    v_cvt_pk_bf16_f32 v39, v34, v35
    v_lshlrev_b32 v28, 16, v36
    v_and_b32 v29, 0xffff0000, v36
    v_lshlrev_b32 v30, 16, v37
    v_and_b32 v31, 0xffff0000, v37
    v_lshlrev_b32 v32, 16, v38
    v_and_b32 v33, 0xffff0000, v38
    v_lshlrev_b32 v34, 16, v39
    v_and_b32 v35, 0xffff0000, v39
    v_mul_f32 v28, 0x3db504f3, v28
    v_mul_f32 v29, 0x3db504f3, v29
    v_mul_f32 v30, 0x3db504f3, v30
    v_mul_f32 v31, 0x3db504f3, v31
    v_mul_f32 v32, 0x3db504f3, v32
    v_mul_f32 v33, 0x3db504f3, v33
    v_mul_f32 v34, 0x3db504f3, v34
    v_mul_f32 v35, 0x3db504f3, v35
    v_cvt_pk_bf16_f32 v36, v28, v29
    v_cvt_pk_bf16_f32 v37, v30, v31
    v_cvt_pk_bf16_f32 v38, v32, v33
    v_cvt_pk_bf16_f32 v39, v34, v35
    v_lshlrev_b32 v28, 16, v36
    v_and_b32 v29, 0xffff0000, v36
    v_lshlrev_b32 v30, 16, v37
    v_and_b32 v31, 0xffff0000, v37
    v_lshlrev_b32 v32, 16, v38
    v_and_b32 v33, 0xffff0000, v38
    v_lshlrev_b32 v34, 16, v39
    v_and_b32 v35, 0xffff0000, v39
    v_max3_f32 v6, v28, v29, v30
    v_max3_f32 v6, v6, v31, v32
    v_max3_f32 v6, v6, v33, v34
    v_max_f32 v6, v6, v35
    v_sub_f32 v28, v28, v6
    v_sub_f32 v29, v29, v6
    v_sub_f32 v30, v30, v6
    v_sub_f32 v31, v31, v6
    v_sub_f32 v32, v32, v6
    v_sub_f32 v33, v33, v6
    v_sub_f32 v34, v34, v6
    v_sub_f32 v35, v35, v6
    v_mul_f32 v28, 0x3fb8aa3b, v28
    v_mul_f32 v29, 0x3fb8aa3b, v29
    v_mul_f32 v30, 0x3fb8aa3b, v30
    v_mul_f32 v31, 0x3fb8aa3b, v31
    v_mul_f32 v32, 0x3fb8aa3b, v32
    v_mul_f32 v33, 0x3fb8aa3b, v33
    v_mul_f32 v34, 0x3fb8aa3b, v34
    v_mul_f32 v35, 0x3fb8aa3b, v35
    v_exp_f32 v28, v28
    v_exp_f32 v29, v29
    v_exp_f32 v30, v30
    v_exp_f32 v31, v31
    v_exp_f32 v32, v32
    v_exp_f32 v33, v33
    v_exp_f32 v34, v34
    v_exp_f32 v35, v35
    s_nop 0
    v_add_f32 v6, v28, v29
    v_add_f32 v6, v6, v30
    v_add_f32 v6, v6, v31
    v_add_f32 v6, v6, v32
    v_add_f32 v6, v6, v33
    v_add_f32 v6, v6, v34
    v_add_f32 v6, v6, v35
    v_rcp_f32 v6, v6
    s_nop 0
    v_mul_f32 v28, v6, v28
    v_mul_f32 v29, v6, v29
    v_mul_f32 v30, v6, v30
    v_mul_f32 v31, v6, v31
    v_mul_f32 v32, v6, v32
    v_mul_f32 v33, v6, v33
    v_mul_f32 v34, v6, v34
    v_mul_f32 v35, v6, v35
    v_cvt_pk_bf16_f32 v36, v28, v29
    v_cvt_pk_bf16_f32 v37, v30, v31
    v_cvt_pk_bf16_f32 v38, v32, v33
    v_cvt_pk_bf16_f32 v39, v34, v35
    v_lshlrev_b32 v28, 16, v36
    v_and_b32 v29, 0xffff0000, v36
    v_lshlrev_b32 v30, 16, v37
    v_and_b32 v31, 0xffff0000, v37
    v_lshlrev_b32 v32, 16, v38
    v_and_b32 v33, 0xffff0000, v38
    v_lshlrev_b32 v34, 16, v39
    v_and_b32 v35, 0xffff0000, v39
    v_mov_b32 v9, 34816
    s_mov_b32 exec_lo, 1
    s_mov_b32 exec_hi, 0
    ds_write_b128 v9, v[28:31]
    ds_write_b128 v9, v[32:35] offset:16
    s_waitcnt lgkmcnt(0)
    s_barrier
L_end:
    s_endpgm
.section .rodata,"a"
.p2align 6
.amdhsa_kernel standalone__low_rank_proj_linformer__decode_kernel
  .amdhsa_next_free_vgpr 184
  .amdhsa_next_free_sgpr 80
  .amdhsa_accum_offset 184
  .amdhsa_group_segment_fixed_size 0
  .amdhsa_kernarg_size 64
  .amdhsa_user_sgpr_count 2
  .amdhsa_user_sgpr_kernarg_segment_ptr 1
  .amdhsa_system_sgpr_workgroup_id_x 1
  .amdhsa_float_denorm_mode_32 3
.end_amdhsa_kernel
```
